```python
import torch

def _softmax(x, axis=-1):
    return torch.softmax(x, dim=axis)
def _gelu(x):
    return torch.nn.functional.gelu(x, approximate="tanh")
def _silu(x):
    return torch.nn.functional.silu(x)
def _sigmoid(x):
    return torch.sigmoid(x)
def _layernorm(x, axis=-1, eps=1e-5):
    m = x.mean(dim=axis, keepdim=True)
    v = x.var(dim=axis, keepdim=True, unbiased=False)
    return (x - m) / torch.sqrt(v + eps)
def _scatter_add(tgt, idx, src, axis=0):
    return tgt.clone().index_add_(axis, idx, src)
def _segment_sum(src, seg, n):
    out = torch.zeros((n,) + src.shape[1:], dtype=src.dtype)
    return out.index_add_(0, seg, src)
def _pad(x, pw):
    flat = tuple(v for pair in reversed(pw) for v in pair)
    return torch.nn.functional.pad(x, flat)

kernel_name = 'gated_mix__sliding_block_cached__dense_activation_silu__decode'

def setup_inputs():

    _w = (lambda a: (lambda t: t.to(torch.bfloat16) if t.is_floating_point() else t)(torch.as_tensor(a)))
    def _A_setup():
        B, Sq, D = 2, 1, 640
        Hq, Hkv, Sk, Dh = 32, 32, 8192, 128
        assert Hq % Hkv == 0, (Hq, Hkv)
        return {
            "x": _w((lambda *s: torch.randn(*s, dtype=torch.bfloat16) * 0.05)(B, Sq, D)),
            "k_cache": _w((lambda *s: torch.randn(*s, dtype=torch.bfloat16) * 6.4)(B, Hkv, Sk, Dh)),
            "v_cache": _w((lambda *s: torch.randn(*s, dtype=torch.bfloat16) * 0.1)(B, Hkv, Sk, Dh)),
            "wq": _w((lambda *s: torch.randn(*s, dtype=torch.bfloat16) * 6.4)(D, Hq * Dh) * (D ** -0.5)),
            "wo": _w((lambda *s: torch.randn(*s, dtype=torch.bfloat16) * 0.1)(Hq * Dh, D) * ((Hq * Dh) ** -0.5)),
        }
    _A_in = _A_setup()

    def _B_setup():
        B, S, D, F = 2, 1, 640, 1728
        return {
            "x": _w((lambda *s: torch.randn(*s, dtype=torch.bfloat16) * 0.05)(B, S, D)),
            "w1": _w((lambda *s: torch.randn(*s, dtype=torch.bfloat16) * 3.2)(D, F) * (D ** -0.5)),
            "w2": _w((lambda *s: torch.randn(*s, dtype=torch.bfloat16) * 0.05)(F, D) * (F ** -0.5)),
        }
    _B_in = _B_setup()

    return {
        "A_x": _A_in["x"],
        "A_k_cache": _A_in["k_cache"],
        "A_v_cache": _A_in["v_cache"],
        "A_wq": _A_in["wq"],
        "A_wo": _A_in["wo"],
        "B_x": _B_in["x"],
        "B_w1": _B_in["w1"],
        "B_w2": _B_in["w2"],
        "gate_w": _w((lambda *s: torch.randn(*s, dtype=torch.bfloat16) * 0.05)(640) * 16.0),
    }

def reference(A_x, A_k_cache, A_v_cache, A_wq, A_wo, B_x, B_w1, B_w2, gate_w):
    def _A_ref(x, k_cache, v_cache, wq, wo):
        B, Sq, D = x.shape
        Hq, Dh = 32, 128
        Hkv, Sk = k_cache.shape[1], k_cache.shape[2]
        W = min(4096, max(256, Sk // 4))
        rep = Hq // Hkv
        q = (lambda x, *d: x.permute(*d))((x @ wq).reshape(B, Sq, Hq, Dh), 0, 2, 1, 3)
        k = (lambda x, n, axis: torch.repeat_interleave(x, n, dim=axis))(k_cache[:, :, Sk - W:, :], rep, axis=1)
        v = (lambda x, n, axis: torch.repeat_interleave(x, n, dim=axis))(v_cache[:, :, Sk - W:, :], rep, axis=1)
        scores = torch.einsum("bhqd,bhkd->bhqk", q, k) * (Dh ** -0.5)
        p = _softmax(scores, axis=-1)
        o = torch.einsum("bhqk,bhkd->bhqd", p, v)
        return (lambda x, *d: x.permute(*d))(o, 0, 2, 1, 3).reshape(B, Sq, Hq * Dh) @ wo

    def _B_ref(x, w1, w2):
        h = torch.einsum("bsd,df->bsf", x, w1)
        h = _silu(h)
        out = torch.einsum("bsf,fd->bsd", h, w2)
        return out

    x = A_x
    g = _sigmoid((x * gate_w).sum(-1, keepdims=True))
    a = _A_ref(x, A_k_cache, A_v_cache, A_wq, A_wo)
    b = _B_ref(x, B_w1, B_w2)
    return g * a + (1 - g) * b
```

```asm
; @launch grid=(256,1,1) block=(1024,1,1) lds=49392
.amdgcn_target "amdgcn-amd-amdhsa--gfx950"
.text
.globl gated_mix__sliding_block_cached__dense_activation_silu__decode_kernel
.p2align 12
.p2align 8
.type gated_mix__sliding_block_cached__dense_activation_silu__decode_kernel,@function
gated_mix__sliding_block_cached__dense_activation_silu__decode_kernel:
    s_cmp_ge_u32 s2, 256
    s_cbranch_scc1 L_end
    s_load_dwordx16 s[4:19], s[0:1], 0
    s_load_dwordx8 s[20:27], s[0:1], 64
    v_lshrrev_b32 v8, 6, v0
    v_and_b32 v1, 63, v0
    v_readfirstlane_b32 s80, v8
    s_and_b32 s76, s2, 7
    s_bfe_u32 s89, s2, 0x20003
    s_lshl3_add_u32 s76, s89, s76
    s_lshr_b32 s77, s2, 5
    v_lshrrev_b32 v9, 4, v1
    v_and_b32 v10, 15, v1
    v_lshl_add_u32 v11, s80, 2, v9
    v_lshlrev_b32 v12, 13, v11
    v_lshl_add_u32 v12, v10, 4, v12
    v_add_u32 v13, 524288, v12
    v_mul_u32_u24 v14, 3456, v11
    v_lshl_add_u32 v14, v10, 4, v14
    v_mov_b32 v15, 0x40000000
    v_cmp_gt_u32 vcc, 8, v10
    s_mul_i32 s89, s77, 80
    s_mul_i32 s90, s77, 655360
    v_cndmask_b32 v14, v15, v14, vcc
    v_add_u32 v15, 221184, v14
    v_add_u32 v66, s89, v11
    v_bfe_u32 v67, v1, 3, 1
    v_mul_u32_u24 v67, 640, v67
    v_add_lshl_u32 v66, v66, v67, 1
    s_lshl_b32 s91, s76, 8
    s_add_u32 s90, s90, s91
    s_mul_i32 s91, s77, 276480
    s_lshl_b32 s92, s76, 7
    s_add_u32 s91, s91, s92
    s_cmp_lt_u32 s76, 27
    s_cselect_b32 s92, 273152, 0
    s_cselect_b32 s93, 80832, 0
    s_lshr_b32 s78, s77, 2
    s_lshl_b32 s70, s78, 5
    s_add_u32 s70, s70, s76
    s_lshl_b32 s70, s70, 4
    s_and_b32 s79, s77, 3
    s_add_u32 s70, s70, s79
    s_add_u32 s70, s70, 12
    s_lshl4_add_u32 s70, s70, s80
    s_lshl_b32 s70, s70, 13
    s_waitcnt lgkmcnt(0)
    s_mov_b64 s[44:45], s[4:5]
    s_mov_b32 s46, 2560
    s_mov_b32 s47, 0x20000
    s_add_u32 s36, s10, s90
    s_addc_u32 s37, s11, 0
    s_mov_b32 s38, 647424
    s_mov_b32 s39, 0x20000
    s_add_u32 s40, s16, s91
    s_addc_u32 s41, s17, 0
    s_mov_b32 s42, s92
    s_mov_b32 s43, 0x20000
    buffer_load_dwordx4 v[48:51], v12, s[36:39], 0 offen nt
    buffer_load_dwordx4 v[52:55], v14, s[40:43], 0 offen nt
    s_mov_b32 exec_lo, 0x1010101
    s_mov_b32 exec_hi, exec_lo
    buffer_load_ushort v64, v66, s[44:47], 0 offen
    s_mov_b64 exec, -1
    s_load_dword s97, s[26:27], 0
    s_cmp_ge_u32 s80, 4
    s_cbranch_scc1 L_notile1
    buffer_load_dwordx4 v[56:59], v13, s[36:39], 0 offen nt
    buffer_load_dwordx4 v[60:63], v15, s[40:43], 0 offen nt
    s_mov_b32 exec_lo, 0x1010101
    s_mov_b32 exec_hi, exec_lo
    buffer_load_ushort v65, v66, s[44:47], 0 offen offset:128
    s_mov_b64 exec, -1
L_notile1:
    s_cmp_lt_u32 s80, 14
    s_cbranch_scc1 L_nogate_ld
    s_mov_b64 s[64:65], s[20:21]
    s_mov_b32 s66, 1280
    s_mov_b32 s67, 0x20000
    s_sub_u32 s90, s80, 14
    s_mul_i32 s90, s90, 1280
    v_lshlrev_b32 v125, 4, v1
    v_lshlrev_b32 v126, 2, v1
    buffer_load_dwordx4 v[112:115], v125, s[44:47], s90 offen
    buffer_load_dword v116, v126, s[44:47], s90 offen offset:1024
    buffer_load_dwordx4 v[120:123], v125, s[64:67], 0 offen
    buffer_load_dword v124, v126, s[64:67], 0 offen offset:1024
L_nogate_ld:
    s_add_u32 s28, s6, s70
    s_addc_u32 s29, s7, 0
    s_mov_b32 s30, 8192
    s_mov_b32 s31, 0x20000
    v_lshrrev_b32 v11, 2, v10
    v_lshlrev_b32 v11, 8, v11
    v_lshl_add_u32 v11, v9, 6, v11
    v_and_b32 v12, 3, v1
    v_lshl_add_u32 v6, v12, 4, v11
    v_lshlrev_b32 v7, 4, v1
    s_lshr_b32 s89, s2, 3
    s_lshr_b32 s90, s80, 1
    s_add_u32 s89, s89, s90
    s_and_b32 s89, s89, 1
    s_lshl_b32 s68, s89, 12
    s_xor_b32 s69, s68, 4096
    s_barrier
    s_cmp_ge_u32 s80, 4
    s_cbranch_scc1 L_noK0
    buffer_load_dwordx4 v[16:19], v6, s[28:31], s68 offen offset:0 nt
    buffer_load_dwordx4 v[20:23], v6, s[28:31], s68 offen offset:1024 nt
    buffer_load_dwordx4 v[24:27], v6, s[28:31], s68 offen offset:2048 nt
    buffer_load_dwordx4 v[28:31], v6, s[28:31], s68 offen offset:3072 nt
    buffer_load_dwordx4 v[32:35], v6, s[28:31], s69 offen offset:0 nt
    buffer_load_dwordx4 v[36:39], v6, s[28:31], s69 offen offset:1024 nt
    buffer_load_dwordx4 v[40:43], v6, s[28:31], s69 offen offset:2048 nt
    buffer_load_dwordx4 v[44:47], v6, s[28:31], s69 offen offset:3072 nt
L_noK0:
    s_add_u32 s32, s8, s70
    s_addc_u32 s33, s9, 0
    s_mov_b32 s34, 8192
    s_mov_b32 s35, 0x20000
    s_mov_b64 s[56:57], s[26:27]
    s_mov_b32 s58, 987136
    s_mov_b32 s59, 0x20000
    s_and_b32 s73, s77, 1
    s_mul_i32 s90, s77, 160
    s_lshl_b32 s91, s73, 5
    s_add_u32 s90, s90, s91
    s_mul_i32 s89, s76, 163840
    s_add_u32 s89, s89, s90
    s_add_u32 s48, s12, s89
    s_addc_u32 s49, s13, 0
    s_mov_b32 s50, 162752
    s_mov_b32 s51, 0x20000
    s_mul_i32 s89, s76, 81920
    s_add_u32 s89, s89, s90
    s_add_u32 s52, s18, s89
    s_addc_u32 s53, s19, 0
    s_mov_b32 s54, s93
    s_mov_b32 s55, 0x20000
    s_lshl_b32 s91, s73, 2
    s_sub_u32 s74, 12, s91
    s_mov_b64 s[60:61], s[22:23]
    s_mov_b32 s62, 2560
    s_mov_b32 s63, 0x20000
    s_mov_b32 s82, 0x07060500
    s_add_u32 s83, s82, 1
    s_add_u32 s84, s82, 2
    s_add_u32 s85, s82, 3
    s_mov_b32 s86, 0x0c0c0400
    s_mov_b32 s87, 0x04000c0c
    s_mov_b32 s94, 0x3fb8aa3b
    s_mov_b32 s95, 0x3db504f3
    s_mov_b32 s96, 0xffff0000
    s_mov_b32 s71, 0xffffff00
    s_getreg_b32 s0, hwreg(HW_REG_XCC_ID, 0, 4)
    s_lshl_b32 s0, s0, 8
    s_mov_b32 s92, 5120
    s_mov_b32 s93, 10240
    s_mov_b32 s72, 15360
    v_and_b32 v11, 1, v1
    v_lshlrev_b32 v11, 4, v11
    v_mov_b32 v12, 0xffff
    v_lshlrev_b32 v12, v11, v12
    v_bfe_u32 v11, v1, 1, 2
    v_cmp_eq_u32 vcc, 0, v11
    s_nop 1
    v_cndmask_b32 v2, 0, v12, vcc
    v_cmp_eq_u32 vcc, 1, v11
    s_nop 1
    v_cndmask_b32 v3, 0, v12, vcc
    v_cmp_eq_u32 vcc, 2, v11
    s_nop 1
    v_cndmask_b32 v4, 0, v12, vcc
    v_cmp_eq_u32 vcc, 3, v11
    s_nop 1
    v_cndmask_b32 v5, 0, v12, vcc
    v_mov_b32 v12, 0x40000000
    v_lshlrev_b32 v11, 4, v10
    v_cmp_gt_u32 vcc, s74, v10
    s_mul_i32 s89, s80, 20480
    s_mul_i32 s90, s80, 10240
    v_cndmask_b32 v11, v12, v11, vcc
    v_mul_u32_u24 v12, 1280, v9
    v_add_u32 v11, v11, v12
    v_add_u32 v94, s89, v11
    v_add_u32 v95, s90, v11
    s_and_b32 s89, s80, 3
    s_lshl_b32 s89, s89, 7
    s_lshl_b32 s90, s76, 14
    s_add_u32 s89, s89, s90
    s_lshl_b32 s90, s78, 9
    s_cmp_lt_u32 s80, 4
    s_cselect_b32 s90, s90, 1024
    s_add_u32 s89, s89, s90
    s_add_u32 s89, s89, 4096
    v_and_b32 v11, 7, v1
    v_lshlrev_b32 v11, 11, v11
    v_lshrrev_b32 v12, 3, v1
    v_lshl_add_u32 v11, v12, 4, v11
    v_add_u32 v87, s89, v11
    s_lshl3_add_u32 s90, s76, s77
    s_lshl_b32 s90, s90, 11
    s_lshl_b32 s89, s80, 10
    s_add_u32 s90, s90, s89
    s_add_u32 s90, s90, 4096
    v_add_u32 v84, s90, v7
    v_add_u32 v85, s89, v7
    s_mul_i32 s89, s80, 1536
    v_and_b32 v11, 7, v1
    v_lshl_add_u32 v11, v9, 5, v11
    v_lshl_add_u32 v11, v11, 2, s89
    v_bfe_u32 v12, v1, 3, 1
    v_lshl_add_u32 v13, v12, 9, v11
    v_lshl_add_u32 v14, v12, 8, v11
    s_cmp_eq_u32 s80, 2
    s_cbranch_scc0 L_nozero
    v_mov_b32 v11, 0
    v_lshlrev_b32 v12, 2, v1
    s_mov_b32 exec_lo, 0xff
    s_mov_b32 exec_hi, 0
    ds_write_b32 v12, v11 offset:37504
    s_mov_b64 exec, -1
L_nozero:
    s_cmp_ge_u32 s80, 4
    s_cbranch_scc1 L_w1late
    s_waitcnt vmcnt(8)
    s_branch L_w1ok
L_w1late:
    s_waitcnt vmcnt(0)
L_w1ok:
    v_lshl_or_b32 v64, v64, 16, v64
    s_nop 1
    v_mov_b32_dpp v64, v64 row_newbcast:0 row_mask:0xf bank_mask:0x3
    s_nop 1
    v_mov_b32_dpp v64, v64 row_newbcast:8 row_mask:0xf bank_mask:0xc
    v_and_b32 v104, v64, v2
    v_and_b32 v105, v64, v3
    v_and_b32 v106, v64, v4
    v_and_b32 v107, v64, v5
    s_nop 1
    v_mfma_f32_16x16x32_bf16 v[96:99], v[48:51], v[104:107], 0
    v_mfma_f32_16x16x32_bf16 v[100:103], v[52:55], v[104:107], 0
    s_cmp_ge_u32 s80, 4
    s_cbranch_scc1 L_nomfma1
    v_lshl_or_b32 v65, v65, 16, v65
    s_nop 1
    v_mov_b32_dpp v65, v65 row_newbcast:0 row_mask:0xf bank_mask:0x3
    s_nop 1
    v_mov_b32_dpp v65, v65 row_newbcast:8 row_mask:0xf bank_mask:0xc
    v_and_b32 v108, v65, v2
    v_and_b32 v109, v65, v3
    v_and_b32 v110, v65, v4
    v_and_b32 v111, v65, v5
    s_nop 1
    v_mfma_f32_16x16x32_bf16 v[96:99], v[56:59], v[108:111], v[96:99]
    v_mfma_f32_16x16x32_bf16 v[100:103], v[60:63], v[108:111], v[100:103]
L_nomfma1:
    s_nop 6
    ds_write_b32 v13, v96 offset:0
    ds_write_b32 v13, v97 offset:32
    ds_write_b32 v13, v98 offset:64
    ds_write_b32 v13, v99 offset:96
    s_mov_b32 exec_lo, -1
    s_mov_b32 exec_hi, 0
    ds_write_b32 v14, v100 offset:1024
    ds_write_b32 v14, v101 offset:1056
    ds_write_b32 v14, v102 offset:1088
    ds_write_b32 v14, v103 offset:1120
    s_mov_b64 exec, -1
    s_waitcnt lgkmcnt(0)
    s_mul_i32 s81, s97, 0x9E3779B1
    s_add_u32 s81, s81, 0x7F4A7C15
    v_mov_b32 v91, s81
    s_barrier
    s_cmp_gt_u32 s80, 1
    s_cbranch_scc1 L_nopub0
    ds_read_b128 v[48:51], v85 offset:0
    ds_read_b128 v[52:55], v85 offset:1536
    ds_read_b128 v[56:59], v85 offset:3072
    ds_read_b128 v[60:63], v85 offset:4608
    ds_read_b128 v[64:67], v85 offset:6144
    ds_read_b128 v[68:71], v85 offset:7680
    ds_read_b128 v[72:75], v85 offset:9216
    ds_read_b128 v[76:79], v85 offset:10752
    s_waitcnt lgkmcnt(4)
    v_pk_add_f32 v[96:97], v[48:49], v[52:53]
    v_pk_add_f32 v[98:99], v[50:51], v[54:55]
    v_pk_add_f32 v[96:97], v[96:97], v[56:57]
    v_pk_add_f32 v[98:99], v[98:99], v[58:59]
    v_pk_add_f32 v[96:97], v[96:97], v[60:61]
    v_pk_add_f32 v[98:99], v[98:99], v[62:63]
    s_waitcnt lgkmcnt(0)
    v_pk_add_f32 v[96:97], v[96:97], v[64:65]
    v_pk_add_f32 v[98:99], v[98:99], v[66:67]
    v_pk_add_f32 v[96:97], v[96:97], v[68:69]
    v_pk_add_f32 v[98:99], v[98:99], v[70:71]
    v_pk_add_f32 v[96:97], v[96:97], v[72:73]
    v_pk_add_f32 v[98:99], v[98:99], v[74:75]
    v_pk_add_f32 v[96:97], v[96:97], v[76:77]
    v_pk_add_f32 v[98:99], v[98:99], v[78:79]
    ds_read_b128 v[48:51], v85 offset:12288
    ds_read_b128 v[52:55], v85 offset:13824
    ds_read_b128 v[56:59], v85 offset:15360
    ds_read_b128 v[60:63], v85 offset:16896
    ds_read_b128 v[64:67], v85 offset:18432
    ds_read_b128 v[68:71], v85 offset:19968
    ds_read_b128 v[72:75], v85 offset:21504
    ds_read_b128 v[76:79], v85 offset:23040
    s_waitcnt lgkmcnt(4)
    v_pk_add_f32 v[96:97], v[96:97], v[48:49]
    v_pk_add_f32 v[98:99], v[98:99], v[50:51]
    v_pk_add_f32 v[96:97], v[96:97], v[52:53]
    v_pk_add_f32 v[98:99], v[98:99], v[54:55]
    v_pk_add_f32 v[96:97], v[96:97], v[56:57]
    v_pk_add_f32 v[98:99], v[98:99], v[58:59]
    v_pk_add_f32 v[96:97], v[96:97], v[60:61]
    v_pk_add_f32 v[98:99], v[98:99], v[62:63]
    s_waitcnt lgkmcnt(0)
    v_pk_add_f32 v[96:97], v[96:97], v[64:65]
    v_pk_add_f32 v[98:99], v[98:99], v[66:67]
    v_pk_add_f32 v[96:97], v[96:97], v[68:69]
    v_pk_add_f32 v[98:99], v[98:99], v[70:71]
    v_pk_add_f32 v[96:97], v[96:97], v[72:73]
    v_pk_add_f32 v[98:99], v[98:99], v[74:75]
    v_pk_add_f32 v[96:97], v[96:97], v[76:77]
    v_pk_add_f32 v[98:99], v[98:99], v[78:79]
    v_perm_b32 v96, v96, v91, s82
    v_perm_b32 v97, v97, v91, s83
    v_perm_b32 v98, v98, v91, s84
    v_perm_b32 v99, v99, v91, s85
    s_cmp_eq_u32 s80, 0
    s_cbranch_scc1 L_pub0_full
    s_mov_b32 exec_lo, -1
    s_mov_b32 exec_hi, 0
L_pub0_full:
    buffer_store_dwordx4 v[96:99], v84, s[56:59], 0 offen
    ds_write_b128 v85, v[96:99] offset:46320
    s_mov_b64 exec, -1
    s_waitcnt lgkmcnt(0)
L_nopub0:
    s_cmp_lt_u32 s80, 4
    s_cbranch_scc1 L_kdone
    s_cmp_lt_u32 s80, 14
    s_cbranch_scc0 L_gate
L_nogate:
    buffer_load_dwordx4 v[16:19], v6, s[28:31], s68 offen offset:0 nt
    buffer_load_dwordx4 v[20:23], v6, s[28:31], s68 offen offset:1024 nt
    buffer_load_dwordx4 v[24:27], v6, s[28:31], s68 offen offset:2048 nt
    buffer_load_dwordx4 v[28:31], v6, s[28:31], s68 offen offset:3072 nt
    buffer_load_dwordx4 v[32:35], v6, s[28:31], s69 offen offset:0 nt
    buffer_load_dwordx4 v[36:39], v6, s[28:31], s69 offen offset:1024 nt
    buffer_load_dwordx4 v[40:43], v6, s[28:31], s69 offen offset:2048 nt
    buffer_load_dwordx4 v[44:47], v6, s[28:31], s69 offen offset:3072 nt
L_kdone:
    s_barrier
    s_cmp_ge_u32 s80, 8
    s_cbranch_scc1 L_nopollq
    buffer_load_dwordx4 v[80:83], v87, s[56:59], 0 offen sc1
L_nopollq:
    buffer_load_dwordx4 v[48:51], v7, s[32:35], s68 offen offset:0 nt
    buffer_load_dwordx4 v[52:55], v7, s[32:35], s68 offen offset:1024 nt
    buffer_load_dwordx4 v[56:59], v7, s[32:35], s68 offen offset:2048 nt
    buffer_load_dwordx4 v[60:63], v7, s[32:35], s68 offen offset:3072 nt
    buffer_load_dwordx4 v[64:67], v7, s[32:35], s69 offen offset:0 nt
    buffer_load_dwordx4 v[68:71], v7, s[32:35], s69 offen offset:1024 nt
    buffer_load_dwordx4 v[72:75], v7, s[32:35], s69 offen offset:2048 nt
    buffer_load_dwordx4 v[76:79], v7, s[32:35], s69 offen offset:3072 nt
    s_cmp_lt_u32 s80, 8
    s_cbranch_scc1 L_nobv
    s_barrier
L_nobv:
    v_bfe_u32 v120, v1, 2, 2
    v_lshl_add_u32 v120, v9, 2, v120
    v_lshlrev_b32 v120, 4, v120
    v_add_u32 v120, 37248, v120
    v_and_b32 v0, 3, v1
    v_mov_b32 v121, 37504
    v_cmp_eq_u32 vcc, 0, v0
    s_nop 1
    v_cndmask_b32 v8, v121, v120, vcc
    v_cmp_eq_u32 vcc, 1, v0
    s_nop 1
    v_cndmask_b32 v11, v121, v120, vcc
    v_cmp_eq_u32 vcc, 2, v0
    s_nop 1
    v_cndmask_b32 v12, v121, v120, vcc
    v_cmp_eq_u32 vcc, 3, v0
    s_nop 1
    v_cndmask_b32 v13, v121, v120, vcc
    s_cmp_lt_u32 s80, 8
    s_cbranch_scc1 L_lo1
    s_waitcnt vmcnt(8)
    s_branch L_qwait
L_lo1:
    s_waitcnt vmcnt(8)
L_p0:
    s_mov_b32 s88, 50000
L_p0l:
    v_perm_b32 v120, v81, v80, s86
    v_perm_b32 v121, v83, v82, s87
    v_or_b32 v120, v120, v121
    v_cmp_ne_u32 vcc, s81, v120
    s_cbranch_vccz L_p0ok
    s_sub_u32 s88, s88, 1
    s_cbranch_scc1 L_p0ok
    s_cmp_eq_u32 s88, 49999
    s_cbranch_scc1 L_p0fb
L_p0re:
    buffer_load_dwordx4 v[80:83], v87, s[56:59], 0 offen sc1
    s_waitcnt vmcnt(0)
    s_branch L_p0l
L_p0ok:
    v_and_b32 v80, s71, v80
    v_and_b32 v81, s71, v81
    v_and_b32 v82, s71, v82
    v_and_b32 v83, s71, v83
    v_add_f32_dpp v80, v80, v80 quad_perm:[1,0,3,2] row_mask:0xf bank_mask:0xf
    v_add_f32_dpp v81, v81, v81 quad_perm:[1,0,3,2] row_mask:0xf bank_mask:0xf
    v_add_f32_dpp v82, v82, v82 quad_perm:[1,0,3,2] row_mask:0xf bank_mask:0xf
    v_add_f32_dpp v83, v83, v83 quad_perm:[1,0,3,2] row_mask:0xf bank_mask:0xf
    v_add_f32_dpp v80, v80, v80 quad_perm:[2,3,0,1] row_mask:0xf bank_mask:0xf
    v_add_f32_dpp v81, v81, v81 quad_perm:[2,3,0,1] row_mask:0xf bank_mask:0xf
    v_add_f32_dpp v82, v82, v82 quad_perm:[2,3,0,1] row_mask:0xf bank_mask:0xf
    v_add_f32_dpp v83, v83, v83 quad_perm:[2,3,0,1] row_mask:0xf bank_mask:0xf
    v_add_f32_dpp v80, v80, v80 row_half_mirror row_mask:0xf bank_mask:0xf
    v_add_f32_dpp v81, v81, v81 row_half_mirror row_mask:0xf bank_mask:0xf
    v_add_f32_dpp v82, v82, v82 row_half_mirror row_mask:0xf bank_mask:0xf
    v_add_f32_dpp v83, v83, v83 row_half_mirror row_mask:0xf bank_mask:0xf
    v_lshrrev_b32 v120, 3, v1
    s_and_b32 s89, s80, 3
    v_lshl_add_u32 v120, s89, 3, v120
    s_cmp_lt_u32 s80, 4
    s_cbranch_scc0 L_hpath
    v_cvt_pk_bf16_f32 v80, v80, v81
    v_cvt_pk_bf16_f32 v81, v82, v83
    v_lshlrev_b32 v121, 3, v120
    s_mov_b32 exec_lo, 0x1010101
    s_mov_b32 exec_hi, exec_lo
    ds_write_b64 v121, v[80:81] offset:37248
    s_mov_b64 exec, 1
    v_mov_b32 v120, 0
    v_mov_b32 v121, 1
    s_waitcnt lgkmcnt(0)
    ds_add_u32 v120, v121 offset:37520
    s_mov_b64 exec, -1
    s_branch L_qwait
L_hpath:
    v_cvt_pk_bf16_f32 v80, v80, v80
    v_cvt_pk_bf16_f32 v81, v81, v81
    v_cvt_pk_bf16_f32 v82, v82, v82
    v_cvt_pk_bf16_f32 v83, v83, v83
    v_and_b32 v80, s96, v80
    v_and_b32 v81, s96, v81
    v_and_b32 v82, s96, v82
    v_and_b32 v83, s96, v83
    v_mul_f32 v122, s94, v80
    v_mul_f32 v123, s94, v81
    v_mul_f32 v124, s94, v82
    v_mul_f32 v125, s94, v83
    v_exp_f32 v122, -v122
    v_exp_f32 v123, -v123
    v_exp_f32 v124, -v124
    v_exp_f32 v125, -v125
    v_add_f32 v122, 1.0, v122
    v_add_f32 v123, 1.0, v123
    v_add_f32 v124, 1.0, v124
    v_add_f32 v125, 1.0, v125
    v_rcp_f32 v122, v122
    v_rcp_f32 v123, v123
    v_rcp_f32 v124, v124
    v_rcp_f32 v125, v125
    v_mul_f32 v80, v80, v122
    v_mul_f32 v81, v81, v123
    v_mul_f32 v82, v82, v124
    v_mul_f32 v83, v83, v125
    v_cvt_pk_bf16_f32 v80, v80, v80
    v_cvt_pk_bf16_f32 v81, v81, v81
    v_cvt_pk_bf16_f32 v82, v82, v82
    v_cvt_pk_bf16_f32 v83, v83, v83
    v_lshlrev_b32 v120, 4, v120
    s_mov_b32 exec_lo, 0x1010101
    s_mov_b32 exec_hi, exec_lo
    ds_write_b128 v120, v[80:83] offset:37536
    s_mov_b64 exec, -1
L_qwait:
    v_mov_b32 v124, 0
    s_mov_b32 s88, 2000000
L_qspin:
    ds_read_b32 v125, v124 offset:37520
    s_waitcnt lgkmcnt(0)
    v_readfirstlane_b32 s89, v125
    s_cmp_ge_u32 s89, 4
    s_cbranch_scc1 L_qspin_ok
    s_sub_u32 s88, s88, 1
    s_cbranch_scc0 L_qspin
L_qspin_ok:
    ds_read_b128 v[96:99], v8
    ds_read_b128 v[100:103], v11
    ds_read_b128 v[104:107], v12
    ds_read_b128 v[108:111], v13
    v_mov_b32 v120, 0xff800000
    s_waitcnt lgkmcnt(0)
    v_mfma_f32_16x16x32_bf16 v[112:115], v[16:19], v[96:99], 0
    v_mfma_f32_16x16x32_bf16 v[116:119], v[32:35], v[96:99], 0
    v_mfma_f32_16x16x32_bf16 v[112:115], v[20:23], v[100:103], v[112:115]
    v_mfma_f32_16x16x32_bf16 v[116:119], v[36:39], v[100:103], v[116:119]
    v_mfma_f32_16x16x32_bf16 v[112:115], v[24:27], v[104:107], v[112:115]
    v_mfma_f32_16x16x32_bf16 v[116:119], v[40:43], v[104:107], v[116:119]
    v_mfma_f32_16x16x32_bf16 v[112:115], v[28:31], v[108:111], v[112:115]
    v_mfma_f32_16x16x32_bf16 v[116:119], v[44:47], v[108:111], v[116:119]
    s_mul_i32 s89, s80, 528
    v_mov_b32 v12, s89
    v_and_b32 v11, 7, v1
    v_lshl_add_u32 v11, v9, 3, v11
    v_lshl_add_u32 v11, v11, 4, s89
    s_nop 1
    v_add_f32_dpp v120, v113, v112 row_shl:4 row_mask:0xf bank_mask:0x1
    s_nop 1
    v_add_f32_dpp v120, v116, v117 row_shr:4 row_mask:0xf bank_mask:0x2
    s_nop 1
    v_add_f32_dpp v120, v114, v120 row_shl:8 row_mask:0xf bank_mask:0x1
    s_nop 1
    v_add_f32_dpp v120, v118, v120 row_shl:4 row_mask:0xf bank_mask:0x2
    s_nop 1
    v_add_f32_dpp v120, v115, v120 row_shl:12 row_mask:0xf bank_mask:0x1
    s_nop 1
    v_add_f32_dpp v120, v119, v120 row_shl:8 row_mask:0xf bank_mask:0x2
    v_cvt_pk_bf16_f32 v120, v120, v120
    v_and_b32 v120, s96, v120
    v_mul_f32 v120, s95, v120
    v_cvt_pk_bf16_f32 v120, v120, v120
    v_and_b32 v120, s96, v120
    v_mov_b32 v90, v120
    s_nop 1
    v_max_f32_dpp v90, v90, v90 quad_perm:[1,0,3,2] row_mask:0xf bank_mask:0xf
    s_nop 1
    v_max_f32_dpp v90, v90, v90 quad_perm:[2,3,0,1] row_mask:0xf bank_mask:0xf
    s_nop 1
    v_max_f32_dpp v90, v90, v90 row_half_mirror row_mask:0xf bank_mask:0xf
    s_nop 1
    v_max_f32_dpp v90, v90, v90 row_mirror row_mask:0xf bank_mask:0xf
    s_nop 1
    v_max_f32_dpp v90, v90, v90 row_bcast:15 row_mask:0xa bank_mask:0xf
    s_nop 1
    v_max_f32_dpp v90, v90, v90 row_bcast:31 row_mask:0xc bank_mask:0xf
    s_nop 0
    v_readlane_b32 s91, v90, 63
    s_mov_b32 exec_lo, 0
    s_mov_b32 exec_hi, 0x80000000
    ds_write_b32 v12, v90 offset:25088
    s_mov_b64 exec, -1
    v_subrev_f32 v120, s91, v120
    v_mul_f32 v120, s94, v120
    v_exp_f32 v120, v120
    v_mov_b32 v124, 0
    v_mov_b32 v125, 1
    s_mov_b64 exec, 1
    s_waitcnt lgkmcnt(0)
    ds_add_u32 v124, v125 offset:37532
    s_mov_b64 exec, -1
    v_cvt_pk_bf16_f32 v121, v120, v120
    s_cmp_lt_u32 s80, 8
    s_cbranch_scc1 L_lowpv
    s_cmp_eq_u32 s80, 15
    s_cbranch_scc0 L_nofac
    s_lshl3_add_u32 s91, s76, s77
    s_lshl_b32 s91, s91, 10
    s_add_u32 s91, s91, 528384
    v_add_u32 v14, s91, v7
    v_mul_u32_u24 v13, 528, v10
    v_mov_b32 v124, 0
    s_mov_b32 s88, 2000000
L_mspin:
    ds_read_b32 v125, v124 offset:37532
    s_waitcnt lgkmcnt(0)
    v_readfirstlane_b32 s89, v125
    s_cmp_ge_u32 s89, 16
    s_cbranch_scc1 L_mspin_ok
    s_sub_u32 s88, s88, 1
    s_cbranch_scc0 L_mspin
L_mspin_ok:
    ds_read_b32 v15, v13 offset:25088
    s_waitcnt lgkmcnt(0)
    v_mov_b32 v90, v15
    s_nop 1
    v_max_f32_dpp v90, v90, v90 quad_perm:[1,0,3,2] row_mask:0xf bank_mask:0xf
    s_nop 1
    v_max_f32_dpp v90, v90, v90 quad_perm:[2,3,0,1] row_mask:0xf bank_mask:0xf
    s_nop 1
    v_max_f32_dpp v90, v90, v90 row_half_mirror row_mask:0xf bank_mask:0xf
    s_nop 1
    v_max_f32_dpp v90, v90, v90 row_mirror row_mask:0xf bank_mask:0xf
    v_sub_f32 v15, v15, v90
    v_mul_f32 v15, s94, v15
    v_exp_f32 v15, v15
    s_nop 1
    v_mov_b32_dpp v16, v15 row_newbcast:0 row_mask:0xf bank_mask:0xf
    v_mov_b32_dpp v17, v15 row_newbcast:1 row_mask:0xf bank_mask:0xf
    v_mov_b32_dpp v18, v15 row_newbcast:2 row_mask:0xf bank_mask:0xf
    v_mov_b32_dpp v19, v15 row_newbcast:3 row_mask:0xf bank_mask:0xf
    v_mov_b32_dpp v20, v15 row_newbcast:4 row_mask:0xf bank_mask:0xf
    v_mov_b32_dpp v21, v15 row_newbcast:5 row_mask:0xf bank_mask:0xf
    v_mov_b32_dpp v22, v15 row_newbcast:6 row_mask:0xf bank_mask:0xf
    v_mov_b32_dpp v23, v15 row_newbcast:7 row_mask:0xf bank_mask:0xf
    v_mov_b32_dpp v24, v15 row_newbcast:8 row_mask:0xf bank_mask:0xf
    v_mov_b32_dpp v25, v15 row_newbcast:9 row_mask:0xf bank_mask:0xf
    v_mov_b32_dpp v26, v15 row_newbcast:10 row_mask:0xf bank_mask:0xf
    v_mov_b32_dpp v27, v15 row_newbcast:11 row_mask:0xf bank_mask:0xf
    v_mov_b32_dpp v28, v15 row_newbcast:12 row_mask:0xf bank_mask:0xf
    v_mov_b32_dpp v29, v15 row_newbcast:13 row_mask:0xf bank_mask:0xf
    v_mov_b32_dpp v30, v15 row_newbcast:14 row_mask:0xf bank_mask:0xf
    v_mov_b32_dpp v31, v15 row_newbcast:15 row_mask:0xf bank_mask:0xf
L_nofac:
    v_and_b32_dpp v96, v121, v2 row_newbcast:0 row_mask:0xf bank_mask:0xf
    v_and_b32_dpp v97, v121, v3 row_newbcast:0 row_mask:0xf bank_mask:0xf
    v_and_b32_dpp v98, v121, v4 row_newbcast:0 row_mask:0xf bank_mask:0xf
    v_and_b32_dpp v99, v121, v5 row_newbcast:0 row_mask:0xf bank_mask:0xf
    v_add_f32_dpp v120, v120, v120 quad_perm:[1,0,3,2] row_mask:0xf bank_mask:0xf
    s_waitcnt vmcnt(7)
    v_mfma_f32_16x16x32_bf16 v[104:107], v[48:51], v[96:99], 0
    v_and_b32_dpp v100, v121, v2 row_newbcast:1 row_mask:0xf bank_mask:0xf
    v_and_b32_dpp v101, v121, v3 row_newbcast:1 row_mask:0xf bank_mask:0xf
    v_and_b32_dpp v102, v121, v4 row_newbcast:1 row_mask:0xf bank_mask:0xf
    v_and_b32_dpp v103, v121, v5 row_newbcast:1 row_mask:0xf bank_mask:0xf
    v_add_f32_dpp v120, v120, v120 quad_perm:[2,3,0,1] row_mask:0xf bank_mask:0xf
    s_waitcnt vmcnt(6)
    v_mfma_f32_16x16x32_bf16 v[104:107], v[52:55], v[100:103], v[104:107]
    v_and_b32_dpp v96, v121, v2 row_newbcast:2 row_mask:0xf bank_mask:0xf
    v_and_b32_dpp v97, v121, v3 row_newbcast:2 row_mask:0xf bank_mask:0xf
    v_and_b32_dpp v98, v121, v4 row_newbcast:2 row_mask:0xf bank_mask:0xf
    v_and_b32_dpp v99, v121, v5 row_newbcast:2 row_mask:0xf bank_mask:0xf
    v_add_f32_dpp v120, v120, v120 row_half_mirror row_mask:0xf bank_mask:0xf
    s_waitcnt vmcnt(5)
    v_mfma_f32_16x16x32_bf16 v[104:107], v[56:59], v[96:99], v[104:107]
    v_and_b32_dpp v100, v121, v2 row_newbcast:3 row_mask:0xf bank_mask:0xf
    v_and_b32_dpp v101, v121, v3 row_newbcast:3 row_mask:0xf bank_mask:0xf
    v_and_b32_dpp v102, v121, v4 row_newbcast:3 row_mask:0xf bank_mask:0xf
    v_and_b32_dpp v103, v121, v5 row_newbcast:3 row_mask:0xf bank_mask:0xf
    v_add_f32_dpp v120, v120, v120 row_mirror row_mask:0xf bank_mask:0xf
    s_waitcnt vmcnt(4)
    v_mfma_f32_16x16x32_bf16 v[104:107], v[60:63], v[100:103], v[104:107]
    v_and_b32_dpp v96, v121, v2 row_newbcast:4 row_mask:0xf bank_mask:0xf
    v_and_b32_dpp v97, v121, v3 row_newbcast:4 row_mask:0xf bank_mask:0xf
    v_and_b32_dpp v98, v121, v4 row_newbcast:4 row_mask:0xf bank_mask:0xf
    v_and_b32_dpp v99, v121, v5 row_newbcast:4 row_mask:0xf bank_mask:0xf
    v_add_f32_dpp v120, v120, v120 row_bcast:15 row_mask:0xa bank_mask:0xf
    s_waitcnt vmcnt(3)
    v_mfma_f32_16x16x32_bf16 v[104:107], v[64:67], v[96:99], v[104:107]
    v_and_b32_dpp v100, v121, v2 row_newbcast:5 row_mask:0xf bank_mask:0xf
    v_and_b32_dpp v101, v121, v3 row_newbcast:5 row_mask:0xf bank_mask:0xf
    v_and_b32_dpp v102, v121, v4 row_newbcast:5 row_mask:0xf bank_mask:0xf
    v_and_b32_dpp v103, v121, v5 row_newbcast:5 row_mask:0xf bank_mask:0xf
    v_add_f32_dpp v120, v120, v120 row_bcast:31 row_mask:0xc bank_mask:0xf
    s_waitcnt vmcnt(2)
    v_mfma_f32_16x16x32_bf16 v[104:107], v[68:71], v[100:103], v[104:107]
    v_and_b32_dpp v96, v121, v2 row_newbcast:6 row_mask:0xf bank_mask:0xf
    v_and_b32_dpp v97, v121, v3 row_newbcast:6 row_mask:0xf bank_mask:0xf
    v_and_b32_dpp v98, v121, v4 row_newbcast:6 row_mask:0xf bank_mask:0xf
    v_and_b32_dpp v99, v121, v5 row_newbcast:6 row_mask:0xf bank_mask:0xf
    s_mov_b32 exec_lo, 0
    s_mov_b32 exec_hi, 0x80000000
    ds_write_b32 v12, v120 offset:25092
    s_mov_b64 exec, -1
    s_waitcnt vmcnt(1)
    v_mfma_f32_16x16x32_bf16 v[104:107], v[72:75], v[96:99], v[104:107]
    v_and_b32_dpp v100, v121, v2 row_newbcast:7 row_mask:0xf bank_mask:0xf
    v_and_b32_dpp v101, v121, v3 row_newbcast:7 row_mask:0xf bank_mask:0xf
    v_and_b32_dpp v102, v121, v4 row_newbcast:7 row_mask:0xf bank_mask:0xf
    v_and_b32_dpp v103, v121, v5 row_newbcast:7 row_mask:0xf bank_mask:0xf
    s_waitcnt vmcnt(0)
    s_nop 0
    v_mfma_f32_16x16x32_bf16 v[104:107], v[76:79], v[100:103], v[104:107]
    v_mov_b32 v8, 0
    v_mov_b32 v12, 1
    s_mov_b32 exec_lo, 0xff00ff
    s_mov_b32 exec_hi, exec_lo
    s_nop 3
    ds_write_b128 v11, v[104:107] offset:24576
    s_mov_b64 exec, 1
    s_waitcnt lgkmcnt(0)
    ds_add_u32 v8, v12 offset:37524
    s_mov_b64 exec, -1
    s_cmp_eq_u32 s80, 15
    s_cbranch_scc0 L_exit
    s_setprio 3
    v_mov_b32 v124, 0
    s_mov_b32 s88, 2000000
L_ospin:
    ds_read_b32 v125, v124 offset:37524
    s_waitcnt lgkmcnt(0)
    v_readfirstlane_b32 s89, v125
    s_cmp_ge_u32 s89, 16
    s_cbranch_scc1 L_ospin_ok
    s_sub_u32 s88, s88, 1
    s_cbranch_scc0 L_ospin
L_ospin_ok:
    s_mov_b32 exec_lo, -1
    s_mov_b32 exec_hi, 1
    ds_read_b128 v[48:51], v7 offset:24576
    ds_read_b128 v[52:55], v7 offset:25104
    ds_read_b128 v[56:59], v7 offset:25632
    ds_read_b128 v[60:63], v7 offset:26160
    ds_read_b128 v[64:67], v7 offset:26688
    ds_read_b128 v[68:71], v7 offset:27216
    ds_read_b128 v[72:75], v7 offset:27744
    ds_read_b128 v[76:79], v7 offset:28272
    s_waitcnt lgkmcnt(7)
    v_pk_mul_f32 v[96:97], v[16:17], v[48:49] op_sel_hi:[0,1]
    v_pk_mul_f32 v[98:99], v[16:17], v[50:51] op_sel_hi:[0,1]
    s_waitcnt lgkmcnt(6)
    v_pk_fma_f32 v[96:97], v[16:17], v[52:53], v[96:97] op_sel:[1,0,0] op_sel_hi:[1,1,1]
    v_pk_fma_f32 v[98:99], v[16:17], v[54:55], v[98:99] op_sel:[1,0,0] op_sel_hi:[1,1,1]
    s_waitcnt lgkmcnt(5)
    v_pk_fma_f32 v[96:97], v[18:19], v[56:57], v[96:97] op_sel_hi:[0,1,1]
    v_pk_fma_f32 v[98:99], v[18:19], v[58:59], v[98:99] op_sel_hi:[0,1,1]
    s_waitcnt lgkmcnt(4)
    v_pk_fma_f32 v[96:97], v[18:19], v[60:61], v[96:97] op_sel:[1,0,0] op_sel_hi:[1,1,1]
    v_pk_fma_f32 v[98:99], v[18:19], v[62:63], v[98:99] op_sel:[1,0,0] op_sel_hi:[1,1,1]
    s_waitcnt lgkmcnt(3)
    v_pk_fma_f32 v[96:97], v[20:21], v[64:65], v[96:97] op_sel_hi:[0,1,1]
    v_pk_fma_f32 v[98:99], v[20:21], v[66:67], v[98:99] op_sel_hi:[0,1,1]
    s_waitcnt lgkmcnt(2)
    v_pk_fma_f32 v[96:97], v[20:21], v[68:69], v[96:97] op_sel:[1,0,0] op_sel_hi:[1,1,1]
    v_pk_fma_f32 v[98:99], v[20:21], v[70:71], v[98:99] op_sel:[1,0,0] op_sel_hi:[1,1,1]
    s_waitcnt lgkmcnt(1)
    v_pk_fma_f32 v[96:97], v[22:23], v[72:73], v[96:97] op_sel_hi:[0,1,1]
    v_pk_fma_f32 v[98:99], v[22:23], v[74:75], v[98:99] op_sel_hi:[0,1,1]
    s_waitcnt lgkmcnt(0)
    v_pk_fma_f32 v[96:97], v[22:23], v[76:77], v[96:97] op_sel:[1,0,0] op_sel_hi:[1,1,1]
    v_pk_fma_f32 v[98:99], v[22:23], v[78:79], v[98:99] op_sel:[1,0,0] op_sel_hi:[1,1,1]
    ds_read_b128 v[48:51], v7 offset:28800
    ds_read_b128 v[52:55], v7 offset:29328
    ds_read_b128 v[56:59], v7 offset:29856
    ds_read_b128 v[60:63], v7 offset:30384
    ds_read_b128 v[64:67], v7 offset:30912
    ds_read_b128 v[68:71], v7 offset:31440
    ds_read_b128 v[72:75], v7 offset:31968
    ds_read_b128 v[76:79], v7 offset:32496
    s_waitcnt lgkmcnt(7)
    v_pk_fma_f32 v[96:97], v[24:25], v[48:49], v[96:97] op_sel_hi:[0,1,1]
    v_pk_fma_f32 v[98:99], v[24:25], v[50:51], v[98:99] op_sel_hi:[0,1,1]
    s_waitcnt lgkmcnt(6)
    v_pk_fma_f32 v[96:97], v[24:25], v[52:53], v[96:97] op_sel:[1,0,0] op_sel_hi:[1,1,1]
    v_pk_fma_f32 v[98:99], v[24:25], v[54:55], v[98:99] op_sel:[1,0,0] op_sel_hi:[1,1,1]
    s_waitcnt lgkmcnt(5)
    v_pk_fma_f32 v[96:97], v[26:27], v[56:57], v[96:97] op_sel_hi:[0,1,1]
    v_pk_fma_f32 v[98:99], v[26:27], v[58:59], v[98:99] op_sel_hi:[0,1,1]
    s_waitcnt lgkmcnt(4)
    v_pk_fma_f32 v[96:97], v[26:27], v[60:61], v[96:97] op_sel:[1,0,0] op_sel_hi:[1,1,1]
    v_pk_fma_f32 v[98:99], v[26:27], v[62:63], v[98:99] op_sel:[1,0,0] op_sel_hi:[1,1,1]
    s_waitcnt lgkmcnt(3)
    v_pk_fma_f32 v[96:97], v[28:29], v[64:65], v[96:97] op_sel_hi:[0,1,1]
    v_pk_fma_f32 v[98:99], v[28:29], v[66:67], v[98:99] op_sel_hi:[0,1,1]
    s_waitcnt lgkmcnt(2)
    v_pk_fma_f32 v[96:97], v[28:29], v[68:69], v[96:97] op_sel:[1,0,0] op_sel_hi:[1,1,1]
    v_pk_fma_f32 v[98:99], v[28:29], v[70:71], v[98:99] op_sel:[1,0,0] op_sel_hi:[1,1,1]
    s_waitcnt lgkmcnt(1)
    v_pk_fma_f32 v[96:97], v[30:31], v[72:73], v[96:97] op_sel_hi:[0,1,1]
    v_pk_fma_f32 v[98:99], v[30:31], v[74:75], v[98:99] op_sel_hi:[0,1,1]
    s_waitcnt lgkmcnt(0)
    v_pk_fma_f32 v[96:97], v[30:31], v[76:77], v[96:97] op_sel:[1,0,0] op_sel_hi:[1,1,1]
    v_pk_fma_f32 v[98:99], v[30:31], v[78:79], v[98:99] op_sel:[1,0,0] op_sel_hi:[1,1,1]
    s_mov_b32 exec_lo, 0
    s_mov_b32 exec_hi, 1
    v_mov_b32 v96, v90
    v_mov_b32 v98, s0
    s_mov_b32 exec_lo, -1
    s_mov_b32 exec_hi, 1
    v_perm_b32 v96, v96, v91, s82
    v_perm_b32 v97, v97, v91, s83
    v_perm_b32 v98, v98, v91, s84
    v_perm_b32 v99, v99, v91, s85
    buffer_store_dwordx4 v[96:99], v14, s[56:59], 0 offen
    ds_write_b128 v7, v[96:99] offset:48368
    s_mov_b64 exec, 1
    s_waitcnt lgkmcnt(0)
    ds_write_b32 v8, v12 offset:37528
    s_waitcnt lgkmcnt(0)
    s_barrier
    s_barrier
    s_endpgm
L_lowpv:
    s_waitcnt lgkmcnt(0)
    s_barrier
    buffer_load_dwordx4 v[16:19], v94, s[48:51], 0 offen nt
    buffer_load_dwordx4 v[20:23], v94, s[48:51], s92 offen nt
    buffer_load_dwordx4 v[24:27], v94, s[48:51], s93 offen nt
    buffer_load_dwordx4 v[28:31], v94, s[48:51], s72 offen nt
    buffer_load_dwordx4 v[32:35], v95, s[52:55], 0 offen nt
    buffer_load_dwordx4 v[36:39], v95, s[52:55], s92 offen nt
    v_bfe_u32 v15, v1, 3, 1
    v_lshlrev_b32 v15, 6, v15
    s_lshl_b32 s90, s80, 3
    v_add3_u32 v15, v15, s90, v9
    v_lshlrev_b32 v15, 2, v15
    v_add_u32 v15, 37536, v15
    ds_read2_b32 v[88:89], v15 offset0:0 offset1:4
    v_and_b32_dpp v96, v121, v2 row_newbcast:0 row_mask:0xf bank_mask:0xf
    v_and_b32_dpp v97, v121, v3 row_newbcast:0 row_mask:0xf bank_mask:0xf
    v_and_b32_dpp v98, v121, v4 row_newbcast:0 row_mask:0xf bank_mask:0xf
    v_and_b32_dpp v99, v121, v5 row_newbcast:0 row_mask:0xf bank_mask:0xf
    v_add_f32_dpp v120, v120, v120 quad_perm:[1,0,3,2] row_mask:0xf bank_mask:0xf
    s_waitcnt vmcnt(6)
    v_mfma_f32_16x16x32_bf16 v[104:107], v[48:51], v[96:99], 0
    v_and_b32_dpp v100, v121, v2 row_newbcast:1 row_mask:0xf bank_mask:0xf
    v_and_b32_dpp v101, v121, v3 row_newbcast:1 row_mask:0xf bank_mask:0xf
    v_and_b32_dpp v102, v121, v4 row_newbcast:1 row_mask:0xf bank_mask:0xf
    v_and_b32_dpp v103, v121, v5 row_newbcast:1 row_mask:0xf bank_mask:0xf
    v_add_f32_dpp v120, v120, v120 quad_perm:[2,3,0,1] row_mask:0xf bank_mask:0xf
    s_nop 0
    v_mfma_f32_16x16x32_bf16 v[104:107], v[52:55], v[100:103], v[104:107]
    v_and_b32_dpp v96, v121, v2 row_newbcast:2 row_mask:0xf bank_mask:0xf
    v_and_b32_dpp v97, v121, v3 row_newbcast:2 row_mask:0xf bank_mask:0xf
    v_and_b32_dpp v98, v121, v4 row_newbcast:2 row_mask:0xf bank_mask:0xf
    v_and_b32_dpp v99, v121, v5 row_newbcast:2 row_mask:0xf bank_mask:0xf
    v_add_f32_dpp v120, v120, v120 row_half_mirror row_mask:0xf bank_mask:0xf
    s_nop 0
    v_mfma_f32_16x16x32_bf16 v[104:107], v[56:59], v[96:99], v[104:107]
    v_and_b32_dpp v100, v121, v2 row_newbcast:3 row_mask:0xf bank_mask:0xf
    v_and_b32_dpp v101, v121, v3 row_newbcast:3 row_mask:0xf bank_mask:0xf
    v_and_b32_dpp v102, v121, v4 row_newbcast:3 row_mask:0xf bank_mask:0xf
    v_and_b32_dpp v103, v121, v5 row_newbcast:3 row_mask:0xf bank_mask:0xf
    v_add_f32_dpp v120, v120, v120 row_mirror row_mask:0xf bank_mask:0xf
    s_nop 0
    v_mfma_f32_16x16x32_bf16 v[104:107], v[60:63], v[100:103], v[104:107]
    v_and_b32_dpp v96, v121, v2 row_newbcast:4 row_mask:0xf bank_mask:0xf
    v_and_b32_dpp v97, v121, v3 row_newbcast:4 row_mask:0xf bank_mask:0xf
    v_and_b32_dpp v98, v121, v4 row_newbcast:4 row_mask:0xf bank_mask:0xf
    v_and_b32_dpp v99, v121, v5 row_newbcast:4 row_mask:0xf bank_mask:0xf
    v_add_f32_dpp v120, v120, v120 row_bcast:15 row_mask:0xa bank_mask:0xf
    s_nop 0
    v_mfma_f32_16x16x32_bf16 v[104:107], v[64:67], v[96:99], v[104:107]
    v_and_b32_dpp v100, v121, v2 row_newbcast:5 row_mask:0xf bank_mask:0xf
    v_and_b32_dpp v101, v121, v3 row_newbcast:5 row_mask:0xf bank_mask:0xf
    v_and_b32_dpp v102, v121, v4 row_newbcast:5 row_mask:0xf bank_mask:0xf
    v_and_b32_dpp v103, v121, v5 row_newbcast:5 row_mask:0xf bank_mask:0xf
    v_add_f32_dpp v120, v120, v120 row_bcast:31 row_mask:0xc bank_mask:0xf
    s_nop 0
    v_mfma_f32_16x16x32_bf16 v[104:107], v[68:71], v[100:103], v[104:107]
    v_and_b32_dpp v96, v121, v2 row_newbcast:6 row_mask:0xf bank_mask:0xf
    v_and_b32_dpp v97, v121, v3 row_newbcast:6 row_mask:0xf bank_mask:0xf
    v_and_b32_dpp v98, v121, v4 row_newbcast:6 row_mask:0xf bank_mask:0xf
    v_and_b32_dpp v99, v121, v5 row_newbcast:6 row_mask:0xf bank_mask:0xf
    s_mov_b32 exec_lo, 0
    s_mov_b32 exec_hi, 0x80000000
    ds_write_b32 v12, v120 offset:25092
    s_mov_b64 exec, -1
    v_mfma_f32_16x16x32_bf16 v[104:107], v[72:75], v[96:99], v[104:107]
    v_and_b32_dpp v100, v121, v2 row_newbcast:7 row_mask:0xf bank_mask:0xf
    v_and_b32_dpp v101, v121, v3 row_newbcast:7 row_mask:0xf bank_mask:0xf
    v_and_b32_dpp v102, v121, v4 row_newbcast:7 row_mask:0xf bank_mask:0xf
    v_and_b32_dpp v103, v121, v5 row_newbcast:7 row_mask:0xf bank_mask:0xf
    s_nop 1
    v_mfma_f32_16x16x32_bf16 v[104:107], v[76:79], v[100:103], v[104:107]
    v_mov_b32 v8, 0
    v_mov_b32 v12, 1
    s_mov_b32 exec_lo, 0xff00ff
    s_mov_b32 exec_hi, exec_lo
    s_nop 3
    ds_write_b128 v11, v[104:107] offset:24576
    s_mov_b64 exec, 1
    s_waitcnt lgkmcnt(0)
    ds_add_u32 v8, v12 offset:37524
    s_mov_b64 exec, -1
    v_and_b32 v120, v88, v2
    v_and_b32 v121, v88, v3
    v_and_b32 v122, v88, v4
    v_and_b32 v123, v88, v5
    v_and_b32 v124, v89, v2
    v_and_b32 v125, v89, v3
    v_and_b32 v126, v89, v4
    v_and_b32 v127, v89, v5
    s_lshl3_add_u32 s91, s76, s80
    s_lshl_b32 s91, s91, 10
    s_add_u32 s91, s91, 528384
    v_add_u32 v14, s91, v7
    s_mov_b32 exec_lo, -1
    s_mov_b32 exec_hi, 1
    buffer_load_dwordx4 v[64:67], v14, s[56:59], 0 offen sc1
    s_mov_b64 exec, -1
    s_mul_i32 s89, s80, 528
    v_add_u32 v15, s89, v7
    s_lshr_b32 s89, s80, 1
    s_lshl_b32 s89, s89, 7
    s_and_b32 s90, s80, 1
    s_lshl3_add_u32 s89, s90, s89
    v_bfe_u32 v12, v1, 3, 1
    v_mul_u32_u24 v13, 2112, v12
    v_lshl_add_u32 v8, v9, 4, v13
    v_add_u32 v8, s89, v8
    v_add_u32 v80, 33024, v8
    v_add_u32 v81, 33552, v8
    v_add_u32 v82, 34080, v8
    v_add_u32 v83, 34608, v8
    v_lshlrev_b32 v12, 3, v12
    ds_read_b64 v[92:93], v12 offset:38112
    s_lshl_b32 s89, s80, 10
    v_add_u32 v84, s89, v7
    v_and_b32 v87, 7, v1
    v_mul_u32_u24 v87, 528, v87
    s_mov_b32 s78, -1
    s_cmp_eq_u32 s73, 0
    s_cselect_b32 s79, 0xffff, 0
    s_and_b32 s89, s76, 1
    s_mul_i32 s89, s89, 640
    s_mul_i32 s90, s77, 80
    s_add_u32 s89, s89, s90
    s_lshl4_add_u32 s89, s73, s89
    s_lshr_b32 s90, s76, 1
    s_lshl_b32 s90, s90, 5
    s_add_u32 s89, s89, s90
    v_add_lshl_u32 v86, s89, v1, 1
    s_mul_i32 s89, s77, 24576
    s_add_u32 s89, s89, 790528
    s_lshl_b32 s90, s76, 12
    s_add_u32 s90, s89, s90
    v_add_u32 v85, s90, v7
    s_cmp_eq_u32 s80, 0
    s_cbranch_scc0 L_addrok
    s_lshl_b32 s90, s76, 7
    s_add_u32 s89, s89, s90
    v_lshrrev_b32 v11, 3, v1
    v_lshlrev_b32 v11, 12, v11
    v_and_b32 v12, 7, v1
    v_lshl_add_u32 v11, v12, 4, v11
    v_add_u32 v85, s89, v11
L_addrok:
    s_mov_b32 exec_lo, -1
    s_mov_b32 exec_hi, 1
    s_mov_b32 s88, 50000
    s_mov_b32 s1, 11
L_pA:
    s_waitcnt vmcnt(0)
    v_perm_b32 v11, v65, v64, s86
    v_perm_b32 v12, v67, v66, s87
    v_or_b32 v11, v11, v12
    v_cmp_ne_u32 vcc, s81, v11
    s_cbranch_vccz L_pAok0
    buffer_load_dwordx4 v[64:67], v14, s[56:59], 0 offen sc1
    s_sub_u32 s88, s88, 1
    s_cbranch_scc1 L_pAok0
    s_sub_u32 s1, s1, 1
    s_cbranch_scc1 L_pAfb
    s_branch L_pA
L_pAok0:
    v_and_b32 v96, s71, v64
    v_and_b32 v97, s71, v65
    v_and_b32 v98, s71, v66
    v_and_b32 v99, s71, v67
L_pAw:
    ds_write_b128 v15, v[96:99] offset:33024
    s_mov_b64 exec, -1
    s_waitcnt lgkmcnt(0)
    s_barrier
    ds_read_b64 v[40:41], v13 offset:33536
    ds_read_b64 v[42:43], v13 offset:34064
    ds_read_b64 v[44:45], v13 offset:34592
    ds_read_b64 v[46:47], v13 offset:35120
    ds_read2_b64 v[96:99], v80 offset0:0 offset1:8
    ds_read2_b64 v[100:103], v81 offset0:0 offset1:8
    ds_read2_b64 v[104:107], v82 offset0:0 offset1:8
    ds_read2_b64 v[108:111], v83 offset0:0 offset1:8
    ds_read_b32 v95, v87 offset:33544
    v_mfma_f32_16x16x32_bf16 v[76:79], v[32:35], v[120:123], 0
    v_mfma_f32_16x16x32_bf16 v[76:79], v[36:39], v[124:127], v[76:79]
    s_waitcnt lgkmcnt(5)
    v_max3_f32 v113, v40, v42, v44
    v_max_f32 v113, v113, v46
    v_sub_f32 v112, v40, v113
    v_sub_f32 v114, v42, v113
    v_sub_f32 v116, v44, v113
    v_sub_f32 v118, v46, v113
    v_mul_f32 v112, s94, v112
    v_mul_f32 v114, s94, v114
    v_mul_f32 v116, s94, v116
    v_mul_f32 v118, s94, v118
    v_exp_f32 v112, v112
    v_exp_f32 v114, v114
    v_exp_f32 v116, v116
    v_exp_f32 v118, v118
    v_mul_f32 v76, v93, v76
    v_mul_f32 v77, v93, v77
    v_mul_f32 v78, v93, v78
    v_mul_f32 v79, v93, v79
    v_mul_f32 v120, v112, v41
    v_fmac_f32 v120, v114, v43
    v_fmac_f32 v120, v116, v45
    v_fmac_f32 v120, v118, v47
    v_rcp_f32 v120, v120
    s_waitcnt lgkmcnt(0)
    v_pk_mul_f32 v[122:123], v[112:113], v[96:97] op_sel_hi:[0,1]
    v_pk_mul_f32 v[124:125], v[112:113], v[98:99] op_sel_hi:[0,1]
    v_mul_f32 v120, v120, v92
    v_pk_fma_f32 v[122:123], v[114:115], v[100:101], v[122:123] op_sel_hi:[0,1,1]
    v_pk_fma_f32 v[124:125], v[114:115], v[102:103], v[124:125] op_sel_hi:[0,1,1]
    v_pk_fma_f32 v[122:123], v[116:117], v[104:105], v[122:123] op_sel_hi:[0,1,1]
    v_pk_fma_f32 v[124:125], v[116:117], v[106:107], v[124:125] op_sel_hi:[0,1,1]
    v_pk_fma_f32 v[122:123], v[118:119], v[108:109], v[122:123] op_sel_hi:[0,1,1]
    v_pk_fma_f32 v[124:125], v[118:119], v[110:111], v[124:125] op_sel_hi:[0,1,1]
    v_pk_mul_f32 v[122:123], v[120:121], v[122:123] op_sel_hi:[0,1]
    v_pk_mul_f32 v[124:125], v[120:121], v[124:125] op_sel_hi:[0,1]
    v_cvt_pk_bf16_f32 v122, v122, v122
    v_cvt_pk_bf16_f32 v123, v123, v123
    v_cvt_pk_bf16_f32 v124, v124, v124
    v_cvt_pk_bf16_f32 v125, v125, v125
    v_and_b32 v48, v122, v2
    v_and_b32 v49, v122, v3
    v_and_b32 v50, v122, v4
    v_and_b32 v51, v122, v5
    v_and_b32 v52, v123, v2
    v_and_b32 v53, v123, v3
    v_and_b32 v54, v123, v4
    v_and_b32 v55, v123, v5
    v_mfma_f32_16x16x32_bf16 v[76:79], v[16:19], v[48:51], v[76:79]
    v_and_b32 v56, v124, v2
    v_and_b32 v57, v124, v3
    v_and_b32 v58, v124, v4
    v_and_b32 v59, v124, v5
    v_mfma_f32_16x16x32_bf16 v[76:79], v[24:27], v[52:55], v[76:79]
    v_and_b32 v60, v125, v2
    v_and_b32 v61, v125, v3
    v_and_b32 v62, v125, v4
    v_and_b32 v63, v125, v5
    v_mfma_f32_16x16x32_bf16 v[76:79], v[20:23], v[56:59], v[76:79]
    s_nop 0
    v_mfma_f32_16x16x32_bf16 v[76:79], v[28:31], v[60:63], v[76:79]
    v_cmp_ne_u32 vcc, s0, v95
    s_cmp_lg_u64 vcc, 0
    s_cselect_b32 s3, 1, 0
    s_nop 4
    ds_write_b128 v84, v[76:79] offset:38128
    s_waitcnt lgkmcnt(0)
    s_barrier
    s_cmp_eq_u32 s80, 0
    s_cbranch_scc0 L_notpub
    s_mov_b64 exec, s[78:79]
    ds_read_b128 v[48:51], v7 offset:38128
    ds_read_b128 v[52:55], v7 offset:39152
    ds_read_b128 v[56:59], v7 offset:40176
    ds_read_b128 v[60:63], v7 offset:41200
    ds_read_b128 v[64:67], v7 offset:42224
    ds_read_b128 v[68:71], v7 offset:43248
    ds_read_b128 v[72:75], v7 offset:44272
    ds_read_b128 v[76:79], v7 offset:45296
    s_waitcnt lgkmcnt(6)
    v_pk_add_f32 v[96:97], v[48:49], v[52:53]
    v_pk_add_f32 v[98:99], v[50:51], v[54:55]
    s_waitcnt lgkmcnt(5)
    v_pk_add_f32 v[96:97], v[96:97], v[56:57]
    v_pk_add_f32 v[98:99], v[98:99], v[58:59]
    s_waitcnt lgkmcnt(4)
    v_pk_add_f32 v[96:97], v[96:97], v[60:61]
    v_pk_add_f32 v[98:99], v[98:99], v[62:63]
    s_waitcnt lgkmcnt(3)
    v_pk_add_f32 v[96:97], v[96:97], v[64:65]
    v_pk_add_f32 v[98:99], v[98:99], v[66:67]
    s_waitcnt lgkmcnt(2)
    v_pk_add_f32 v[96:97], v[96:97], v[68:69]
    v_pk_add_f32 v[98:99], v[98:99], v[70:71]
    s_waitcnt lgkmcnt(1)
    v_pk_add_f32 v[96:97], v[96:97], v[72:73]
    v_pk_add_f32 v[98:99], v[98:99], v[74:75]
    s_waitcnt lgkmcnt(0)
    v_pk_add_f32 v[96:97], v[96:97], v[76:77]
    v_pk_add_f32 v[98:99], v[98:99], v[78:79]
    v_perm_b32 v96, v96, v91, s82
    v_perm_b32 v97, v97, v91, s83
    v_perm_b32 v98, v98, v91, s84
    v_perm_b32 v99, v99, v91, s85
    buffer_store_dwordx4 v[96:99], v85, s[56:59], 0 offen sc1
    s_cmp_eq_u32 s3, 0
    s_cbranch_scc0 L_remA
L_exit:
    s_endpgm
L_notpub:
    s_cmp_eq_u32 s80, 1
    s_cbranch_scc0 L_exit
    s_lshl_b32 s89, s73, 1
    s_sub_u32 s89, 6, s89
    s_cmp_lt_u32 s76, s89
    s_cbranch_scc0 L_exit
    s_mov_b32 s88, 50000
    buffer_load_dwordx4 v[16:19], v85, s[56:59], 0 offen offset:0 sc1
    buffer_load_dwordx4 v[20:23], v85, s[56:59], 0 offen offset:1024 sc1
    buffer_load_dwordx4 v[24:27], v85, s[56:59], 0 offen offset:2048 sc1
    buffer_load_dwordx4 v[28:31], v85, s[56:59], 0 offen offset:3072 sc1
    buffer_load_dwordx4 v[32:35], v85, s[56:59], 0 offen offset:0 sc1
    buffer_load_dwordx4 v[36:39], v85, s[56:59], 0 offen offset:1024 sc1
    buffer_load_dwordx4 v[40:43], v85, s[56:59], 0 offen offset:2048 sc1
    buffer_load_dwordx4 v[44:47], v85, s[56:59], 0 offen offset:3072 sc1
    buffer_load_dwordx4 v[48:51], v85, s[56:59], 0 offen offset:0 sc1
    buffer_load_dwordx4 v[52:55], v85, s[56:59], 0 offen offset:1024 sc1
    buffer_load_dwordx4 v[56:59], v85, s[56:59], 0 offen offset:2048 sc1
    buffer_load_dwordx4 v[60:63], v85, s[56:59], 0 offen offset:3072 sc1
L_pB:
    s_waitcnt vmcnt(8)
    v_perm_b32 v96, v17, v16, s86
    v_perm_b32 v97, v19, v18, s87
    v_perm_b32 v98, v21, v20, s86
    v_perm_b32 v99, v23, v22, s87
    v_perm_b32 v100, v25, v24, s86
    v_perm_b32 v101, v27, v26, s87
    v_perm_b32 v102, v29, v28, s86
    v_perm_b32 v103, v31, v30, s87
    v_or_b32 v96, v96, v97
    v_or_b32 v98, v98, v99
    v_or_b32 v100, v100, v101
    v_or_b32 v102, v102, v103
    v_xor_b32 v96, s81, v96
    v_xor_b32 v98, s81, v98
    v_xor_b32 v100, s81, v100
    v_xor_b32 v102, s81, v102
    v_or3_b32 v96, v96, v98, v100
    v_or_b32 v96, v96, v102
    v_cmp_ne_u32 vcc, 0, v96
    s_cbranch_vccz L_pBok0
    buffer_load_dwordx4 v[16:19], v85, s[56:59], 0 offen offset:0 sc1
    buffer_load_dwordx4 v[20:23], v85, s[56:59], 0 offen offset:1024 sc1
    buffer_load_dwordx4 v[24:27], v85, s[56:59], 0 offen offset:2048 sc1
    buffer_load_dwordx4 v[28:31], v85, s[56:59], 0 offen offset:3072 sc1
    s_waitcnt vmcnt(8)
    v_perm_b32 v96, v33, v32, s86
    v_perm_b32 v97, v35, v34, s87
    v_perm_b32 v98, v37, v36, s86
    v_perm_b32 v99, v39, v38, s87
    v_perm_b32 v100, v41, v40, s86
    v_perm_b32 v101, v43, v42, s87
    v_perm_b32 v102, v45, v44, s86
    v_perm_b32 v103, v47, v46, s87
    v_or_b32 v96, v96, v97
    v_or_b32 v98, v98, v99
    v_or_b32 v100, v100, v101
    v_or_b32 v102, v102, v103
    v_xor_b32 v96, s81, v96
    v_xor_b32 v98, s81, v98
    v_xor_b32 v100, s81, v100
    v_xor_b32 v102, s81, v102
    v_or3_b32 v96, v96, v98, v100
    v_or_b32 v96, v96, v102
    v_cmp_ne_u32 vcc, 0, v96
    s_cbranch_vccz L_pBok1
    buffer_load_dwordx4 v[32:35], v85, s[56:59], 0 offen offset:0 sc1
    buffer_load_dwordx4 v[36:39], v85, s[56:59], 0 offen offset:1024 sc1
    buffer_load_dwordx4 v[40:43], v85, s[56:59], 0 offen offset:2048 sc1
    buffer_load_dwordx4 v[44:47], v85, s[56:59], 0 offen offset:3072 sc1
    s_waitcnt vmcnt(8)
    v_perm_b32 v96, v49, v48, s86
    v_perm_b32 v97, v51, v50, s87
    v_perm_b32 v98, v53, v52, s86
    v_perm_b32 v99, v55, v54, s87
    v_perm_b32 v100, v57, v56, s86
    v_perm_b32 v101, v59, v58, s87
    v_perm_b32 v102, v61, v60, s86
    v_perm_b32 v103, v63, v62, s87
    v_or_b32 v96, v96, v97
    v_or_b32 v98, v98, v99
    v_or_b32 v100, v100, v101
    v_or_b32 v102, v102, v103
    v_xor_b32 v96, s81, v96
    v_xor_b32 v98, s81, v98
    v_xor_b32 v100, s81, v100
    v_xor_b32 v102, s81, v102
    v_or3_b32 v96, v96, v98, v100
    v_or_b32 v96, v96, v102
    v_cmp_ne_u32 vcc, 0, v96
    s_cbranch_vccz L_pBok2
    buffer_load_dwordx4 v[48:51], v85, s[56:59], 0 offen offset:0 sc1
    buffer_load_dwordx4 v[52:55], v85, s[56:59], 0 offen offset:1024 sc1
    buffer_load_dwordx4 v[56:59], v85, s[56:59], 0 offen offset:2048 sc1
    buffer_load_dwordx4 v[60:63], v85, s[56:59], 0 offen offset:3072 sc1
    s_sub_u32 s88, s88, 1
    s_cbranch_scc0 L_pB
L_pBok0:
    v_and_b32 v104, s71, v16
    v_and_b32 v105, s71, v17
    v_and_b32 v106, s71, v18
    v_and_b32 v107, s71, v19
    v_and_b32 v108, s71, v20
    v_and_b32 v109, s71, v21
    v_and_b32 v110, s71, v22
    v_and_b32 v111, s71, v23
    v_and_b32 v112, s71, v24
    v_and_b32 v113, s71, v25
    v_and_b32 v114, s71, v26
    v_and_b32 v115, s71, v27
    v_and_b32 v116, s71, v28
    v_and_b32 v117, s71, v29
    v_and_b32 v118, s71, v30
    v_and_b32 v119, s71, v31
    s_branch L_pBw
L_pBok1:
    v_and_b32 v104, s71, v32
    v_and_b32 v105, s71, v33
    v_and_b32 v106, s71, v34
    v_and_b32 v107, s71, v35
    v_and_b32 v108, s71, v36
    v_and_b32 v109, s71, v37
    v_and_b32 v110, s71, v38
    v_and_b32 v111, s71, v39
    v_and_b32 v112, s71, v40
    v_and_b32 v113, s71, v41
    v_and_b32 v114, s71, v42
    v_and_b32 v115, s71, v43
    v_and_b32 v116, s71, v44
    v_and_b32 v117, s71, v45
    v_and_b32 v118, s71, v46
    v_and_b32 v119, s71, v47
    s_branch L_pBw
L_pBok2:
    v_and_b32 v104, s71, v48
    v_and_b32 v105, s71, v49
    v_and_b32 v106, s71, v50
    v_and_b32 v107, s71, v51
    v_and_b32 v108, s71, v52
    v_and_b32 v109, s71, v53
    v_and_b32 v110, s71, v54
    v_and_b32 v111, s71, v55
    v_and_b32 v112, s71, v56
    v_and_b32 v113, s71, v57
    v_and_b32 v114, s71, v58
    v_and_b32 v115, s71, v59
    v_and_b32 v116, s71, v60
    v_and_b32 v117, s71, v61
    v_and_b32 v118, s71, v62
    v_and_b32 v119, s71, v63
L_pBw:
    v_pk_add_f32 v[104:105], v[104:105], v[108:109]
    v_pk_add_f32 v[106:107], v[106:107], v[110:111]
    v_pk_add_f32 v[112:113], v[112:113], v[116:117]
    v_pk_add_f32 v[114:115], v[114:115], v[118:119]
    v_pk_add_f32 v[104:105], v[104:105], v[112:113]
    v_pk_add_f32 v[106:107], v[106:107], v[114:115]
    s_nop 0
    v_add_f32_dpp v104, v104, v104 row_ror:8 row_mask:0xf bank_mask:0xf
    v_add_f32_dpp v105, v105, v105 row_ror:8 row_mask:0xf bank_mask:0xf
    v_add_f32_dpp v106, v106, v106 row_ror:8 row_mask:0xf bank_mask:0xf
    v_add_f32_dpp v107, v107, v107 row_ror:8 row_mask:0xf bank_mask:0xf
    v_mov_b32 v108, v104
    v_mov_b32 v109, v105
    v_mov_b32 v110, v106
    v_mov_b32 v111, v107
    v_permlane16_swap_b32 v104, v108
    v_permlane16_swap_b32 v105, v109
    v_permlane16_swap_b32 v106, v110
    v_permlane16_swap_b32 v107, v111
    v_add_f32 v104, v104, v108
    v_add_f32 v105, v105, v109
    v_add_f32 v106, v106, v110
    v_add_f32 v107, v107, v111
    v_mov_b32 v108, v104
    v_mov_b32 v109, v105
    v_mov_b32 v110, v106
    v_mov_b32 v111, v107
    v_permlane32_swap_b32 v104, v108
    v_permlane32_swap_b32 v105, v109
    v_permlane32_swap_b32 v106, v110
    v_permlane32_swap_b32 v107, v111
    v_add_f32 v104, v104, v108
    v_add_f32 v105, v105, v109
    v_add_f32 v106, v106, v110
    v_add_f32 v107, v107, v111
    v_cvt_pk_bf16_f32 v104, v104, v104
    v_cvt_pk_bf16_f32 v105, v105, v105
    v_cvt_pk_bf16_f32 v106, v106, v106
    v_cvt_pk_bf16_f32 v107, v107, v107
    s_mov_b32 exec_lo, 0xff
    s_mov_b32 exec_hi, 0
    buffer_store_short v104, v86, s[60:63], 0 offen offset:0
    buffer_store_short v105, v86, s[60:63], 0 offen offset:16
    buffer_store_short v106, v86, s[60:63], 0 offen offset:32
    buffer_store_short v107, v86, s[60:63], 0 offen offset:48
    s_cmp_eq_u32 s2, 0
    s_cbranch_scc0 L_done
    s_mov_b64 exec, 1
    v_mov_b32 v12, 0
    buffer_store_dword v91, v12, s[56:59], 0 offen sc1
    s_branch L_done
L_done:
L_end:
    s_endpgm
L_gate:
    v_mov_b32 v118, 0
    v_lshlrev_b32 v107, 16, v112
    v_lshlrev_b32 v108, 16, v120
    v_and_b32 v112, s96, v112
    v_and_b32 v120, s96, v120
    v_mul_f32 v107, v107, v108
    v_mul_f32 v108, v112, v120
    v_cvt_pk_bf16_f32 v107, v107, v108
    v_lshlrev_b32 v108, 16, v107
    v_and_b32 v107, s96, v107
    v_add_f32 v118, v118, v108
    v_add_f32 v118, v118, v107
    v_lshlrev_b32 v107, 16, v113
    v_lshlrev_b32 v108, 16, v121
    v_and_b32 v113, s96, v113
    v_and_b32 v121, s96, v121
    v_mul_f32 v107, v107, v108
    v_mul_f32 v108, v113, v121
    v_cvt_pk_bf16_f32 v107, v107, v108
    v_lshlrev_b32 v108, 16, v107
    v_and_b32 v107, s96, v107
    v_add_f32 v118, v118, v108
    v_add_f32 v118, v118, v107
    v_lshlrev_b32 v107, 16, v114
    v_lshlrev_b32 v108, 16, v122
    v_and_b32 v114, s96, v114
    v_and_b32 v122, s96, v122
    v_mul_f32 v107, v107, v108
    v_mul_f32 v108, v114, v122
    v_cvt_pk_bf16_f32 v107, v107, v108
    v_lshlrev_b32 v108, 16, v107
    v_and_b32 v107, s96, v107
    v_add_f32 v118, v118, v108
    v_add_f32 v118, v118, v107
    v_lshlrev_b32 v107, 16, v115
    v_lshlrev_b32 v108, 16, v123
    v_and_b32 v115, s96, v115
    v_and_b32 v123, s96, v123
    v_mul_f32 v107, v107, v108
    v_mul_f32 v108, v115, v123
    v_cvt_pk_bf16_f32 v107, v107, v108
    v_lshlrev_b32 v108, 16, v107
    v_and_b32 v107, s96, v107
    v_add_f32 v118, v118, v108
    v_add_f32 v118, v118, v107
    v_lshlrev_b32 v107, 16, v116
    v_lshlrev_b32 v108, 16, v124
    v_and_b32 v116, s96, v116
    v_and_b32 v124, s96, v124
    v_mul_f32 v107, v107, v108
    v_mul_f32 v108, v116, v124
    v_cvt_pk_bf16_f32 v107, v107, v108
    v_lshlrev_b32 v108, 16, v107
    v_and_b32 v107, s96, v107
    v_add_f32 v118, v118, v108
    v_add_f32 v118, v118, v107
    s_nop 1
    v_add_f32_dpp v118, v118, v118 quad_perm:[1,0,3,2] row_mask:0xf bank_mask:0xf
    s_nop 1
    v_add_f32_dpp v118, v118, v118 quad_perm:[2,3,0,1] row_mask:0xf bank_mask:0xf
    s_nop 1
    v_add_f32_dpp v118, v118, v118 row_half_mirror row_mask:0xf bank_mask:0xf
    s_nop 1
    v_add_f32_dpp v118, v118, v118 row_mirror row_mask:0xf bank_mask:0xf
    s_nop 1
    v_add_f32_dpp v118, v118, v118 row_bcast:15 row_mask:0xa bank_mask:0xf
    s_nop 1
    v_add_f32_dpp v118, v118, v118 row_bcast:31 row_mask:0xc bank_mask:0xf
    v_cvt_pk_bf16_f32 v118, v118, v118
    v_and_b32 v118, s96, v118
    v_mul_f32 v118, s94, v118
    v_exp_f32 v118, -v118
    s_nop 0
    v_add_f32 v118, 1.0, v118
    v_rcp_f32 v118, v118
    s_nop 0
    v_cvt_pk_bf16_f32 v118, v118, v118
    v_and_b32 v118, s96, v118
    v_sub_f32 v107, 1.0, v118
    v_cvt_pk_bf16_f32 v107, v107, v107
    v_and_b32 v107, s96, v107
    s_sub_u32 s90, s80, 14
    s_lshl_b32 s90, s90, 3
    v_mov_b32 v119, v107
    v_mov_b32 v108, s90
    s_mov_b32 exec_lo, 0
    s_mov_b32 exec_hi, 0x80000000
    ds_write_b64 v108, v[118:119] offset:38112
    s_mov_b64 exec, -1
    s_branch L_nogate
L_p0fb:
    ds_read_b128 v[104:107], v7 offset:46320
    ds_read_b128 v[108:111], v7 offset:47344
    s_lshl3_add_u32 s90, s76, s77
    s_lshl_b32 s90, s90, 11
    s_add_u32 s90, s90, 4096
    v_add_u32 v122, s90, v7
    s_waitcnt lgkmcnt(0)
    buffer_store_dwordx4 v[104:107], v122, s[56:59], 0 offen sc1
    s_mov_b32 exec_lo, -1
    s_mov_b32 exec_hi, 0
    buffer_store_dwordx4 v[108:111], v122, s[56:59], 0 offen offset:1024 sc1
    s_mov_b64 exec, -1
    s_branch L_p0re
L_pAfb:
    s_mov_b32 s1, 11
    s_mov_b64 exec, -1
    ds_read_b128 v[104:107], v7 offset:46320
    ds_read_b128 v[108:111], v7 offset:47344
    s_lshl3_add_u32 s90, s76, s77
    s_lshl_b32 s90, s90, 11
    s_add_u32 s90, s90, 4096
    v_add_u32 v112, s90, v7
    s_waitcnt lgkmcnt(0)
    buffer_store_dwordx4 v[104:107], v112, s[56:59], 0 offen sc1
    s_mov_b32 exec_lo, -1
    s_mov_b32 exec_hi, 0
    buffer_store_dwordx4 v[108:111], v112, s[56:59], 0 offen offset:1024 sc1
    s_mov_b64 exec, -1
    v_mov_b32 v112, 0
    ds_read_b32 v113, v112 offset:37528
    s_waitcnt lgkmcnt(0)
    v_readfirstlane_b32 s90, v113
    s_cmp_eq_u32 s90, 0
    s_cbranch_scc1 L_pAfb2
    s_mov_b32 exec_lo, -1
    s_mov_b32 exec_hi, 1
    ds_read_b128 v[104:107], v7 offset:48368
    s_lshl3_add_u32 s90, s76, s77
    s_lshl_b32 s90, s90, 10
    s_add_u32 s90, s90, 528384
    v_add_u32 v112, s90, v7
    s_waitcnt lgkmcnt(0)
    buffer_store_dwordx4 v[104:107], v112, s[56:59], 0 offen sc1
L_pAfb2:
    s_mov_b32 exec_lo, -1
    s_mov_b32 exec_hi, 1
    s_branch L_pA
L_remA:
    s_mov_b32 exec_lo, -1
    s_mov_b32 exec_hi, 1
    ds_read_b128 v[48:51], v7 offset:48368
    s_lshl3_add_u32 s90, s76, s77
    s_lshl_b32 s90, s90, 10
    s_add_u32 s90, s90, 528384
    v_add_u32 v52, s90, v7
    s_waitcnt lgkmcnt(0)
    buffer_store_dwordx4 v[48:51], v52, s[56:59], 0 offen sc1
    s_endpgm
.section .rodata,"a"
.p2align 6
.amdhsa_kernel gated_mix__sliding_block_cached__dense_activation_silu__decode_kernel
  .amdhsa_next_free_vgpr 128
  .amdhsa_next_free_sgpr 102
  .amdhsa_accum_offset 128
  .amdhsa_group_segment_fixed_size 0
  .amdhsa_kernarg_size 96
  .amdhsa_user_sgpr_count 2
  .amdhsa_user_sgpr_kernarg_segment_ptr 1
  .amdhsa_system_sgpr_workgroup_id_x 1
.end_amdhsa_kernel
```
